```python
import torch

def _softmax(x, axis=-1):
    return torch.softmax(x, dim=axis)
def _gelu(x):
    return torch.nn.functional.gelu(x, approximate="tanh")
def _silu(x):
    return torch.nn.functional.silu(x)
def _sigmoid(x):
    return torch.sigmoid(x)
def _layernorm(x, axis=-1, eps=1e-5):
    m = x.mean(dim=axis, keepdim=True)
    v = x.var(dim=axis, keepdim=True, unbiased=False)
    return (x - m) / torch.sqrt(v + eps)
def _scatter_add(tgt, idx, src, axis=0):
    return tgt.clone().index_add_(axis, idx, src)
def _segment_sum(src, seg, n):
    out = torch.zeros((n,) + src.shape[1:], dtype=src.dtype)
    return out.index_add_(0, seg, src)
def _pad(x, pw):
    flat = tuple(v for pair in reversed(pw) for v in pair)
    return torch.nn.functional.pad(x, flat)

kernel_name = 'standalone__linear_kernel_rfa__sampling'

def setup_inputs():

    _w = (lambda a: (lambda t: t.to(torch.bfloat16) if t.is_floating_point() else t)(torch.as_tensor(a)))
    B, H, Sq, Sk, D, M = 8, 32, 32, 2048, 128, 8
    return {
        "q": _w((lambda *s: torch.randn(*s, dtype=torch.bfloat16) * 0.05)(B, H, Sq, D)),
        "k": _w((lambda *s: torch.randn(*s, dtype=torch.bfloat16) * 0.4)(B, H, Sk, D)),
        "v": _w((lambda *s: torch.randn(*s, dtype=torch.bfloat16) * 0.4)(B, H, Sk, D)),
        "omega": _w((lambda *s: torch.randn(*s, dtype=torch.bfloat16) * 0.8)(M, D)),
    }

def reference(q, k, v, omega):
    d = q.shape[-1]
    m = omega.shape[0]
    scale = float(d) ** -0.25
    qs = q * scale
    ks = k * scale
    q_proj = torch.einsum("bhsd,md->bhsm", qs, omega)
    k_proj = torch.einsum("bhsd,md->bhsm", ks, omega)
    q_sq = 0.5 * torch.einsum("bhsd,bhsd->bhs", qs, qs)[..., None]
    k_sq = 0.5 * torch.einsum("bhsd,bhsd->bhs", ks, ks)[..., None]
    inv_sqrt_m = float(m) ** -0.5
    phi_q = torch.exp(q_proj - q_sq) * inv_sqrt_m + 1e-6
    phi_k = torch.exp(k_proj - k_sq) * inv_sqrt_m + 1e-6
    kv = torch.einsum("bhsm,bhsd->bhmd", phi_k, v)
    z  = torch.einsum("bhsm->bhm", phi_k)
    num = torch.einsum("bhqm,bhmd->bhqd", phi_q, kv)
    den = torch.einsum("bhqm,bhm->bhq", phi_q, z)[..., None] + 1e-6
    return num / den
```

```asm
; @launch grid=(256,1,1) block=(256,1,1) lds=134144
.amdgcn_target "amdgcn-amd-amdhsa--gfx950"
.text
.globl standalone__linear_kernel_rfa__sampling_kernel
.p2align 8
.type standalone__linear_kernel_rfa__sampling_kernel,@function
standalone__linear_kernel_rfa__sampling_kernel:
  s_load_dwordx2 s[28:29], s[0:1], 24
  s_load_dwordx2 s[24:25], s[0:1], 0
  s_load_dwordx2 s[16:17], s[0:1], 8
  s_load_dwordx2 s[20:21], s[0:1], 16
  s_load_dwordx2 s[32:33], s[0:1], 32
  s_load_dwordx2 s[12:13], s[0:1], 40
  s_cmp_ge_u32 s2, 256
  s_cbranch_scc1 L_end
  v_lshrrev_b32 v19, 6, v0
  v_and_b32 v22, 63, v0
  v_readfirstlane_b32 s36, v19
  v_lshlrev_b32 v1, 4, v22
  v_bfe_u32 v21, v0, 4, 2
  v_lshlrev_b32 v20, 6, v21
  v_xor_b32 v2, v1, v20
  v_xor_b32 v3, 16, v2
  v_xor_b32 v4, 32, v2
  v_xor_b32 v5, 48, v2
  s_and_b32 s3, s2, 7
  s_lshl_b32 s3, s3, 5
  s_lshr_b32 s2, s2, 3
  s_or_b32 s2, s2, s3
  s_lshl_b32 s4, s2, 19
  s_lshl_b32 s5, s2, 13
  s_lshl_b32 s38, s36, 12
  s_lshl_b32 s39, s36, 14
  s_add_u32 s40, s39, 0x3000
  s_lshl_b32 s41, s36, 11
  s_bfe_u32 s3, s2, 0x10001
  s_lshl_b32 s3, s3, 17
  s_xor_b32 s38, s38, s3
  s_bfe_u32 s3, s2, 0x10004
  s_lshl_b32 s3, s3, 18
  s_xor_b32 s38, s38, s3
  s_mov_b32 s37, s38
  s_mov_b32 s7, 0
  s_mov_b32 s30, 0x800
  s_mov_b32 s31, 0x20000
  s_mov_b32 s26, 0x2000
  s_mov_b32 s27, 0x20000
  s_mov_b32 s18, 0x80000
  s_mov_b32 s19, 0x20000
  s_mov_b32 s22, 0x80000
  s_mov_b32 s23, 0x20000
  s_mov_b32 m0, s40
  s_waitcnt lgkmcnt(0)
  buffer_load_dwordx4 v2, s[28:31], 0 offen offset:0 lds
  buffer_load_dwordx4 v3, s[28:31], 0 offen offset:1024 lds
  s_add_u32 m0, s40, 2048
  s_add_u32 s24, s24, s5
  s_addc_u32 s25, s25, 0
  buffer_load_dwordx4 v2, s[24:27], s41 offen offset:0 nt lds
  buffer_load_dwordx4 v3, s[24:27], s41 offen offset:1024 nt lds
  s_mov_b32 m0, s39
  s_add_u32 s16, s16, s4
  s_addc_u32 s17, s17, 0
  buffer_load_dwordx4 v2, s[16:19], s37 offen offset:0 nt lds
  buffer_load_dwordx4 v3, s[16:19], s37 offen offset:1024 nt lds
  buffer_load_dwordx4 v4, s[16:19], s37 offen offset:2048 nt lds
  s_mov_b32 s10, 0
  s_add_u32 s20, s20, s4
  s_addc_u32 s21, s21, 0
  s_add_u32 s32, s32, s5
  s_addc_u32 s33, s33, 0
  s_mov_b32 s34, 0x2000
  s_mov_b32 s35, 0x20000
  s_mov_b32 s14, 256
  s_mov_b32 s15, 0x20000
  v_and_b32 v20, 15, v0
  v_mov_b32 v12, 0x3edb9ada
  v_mov_b32 v13, 0xbfc00000
  v_mov_b32 v14, 0xbe1837f0
  v_mov_b32 v15, 1.0
  v_bfe_u32 v17, v0, 1, 1
  v_lshlrev_b32 v17, 4, v17
  v_mov_b32 v10, 0x0c0c0100
  v_mov_b32 v11, 0x0c0c0302
  v_alignbit_b32 v10, v10, v10, v17
  v_alignbit_b32 v11, v11, v11, v17
  v_and_b32 v17, 3, v0
  v_bfe_u32 v18, v0, 2, 2
  v_lshl_add_u32 v16, v17, 2, v18
  v_xor_b32 v6, v21, v20
  v_lshlrev_b32 v6, 4, v6
  v_lshl_add_u32 v6, v16, 8, v6
  v_add_u32 v6, s39, v6
  v_xor_b32 v7, 64, v6
  v_xor_b32 v8, 128, v6
  v_xor_b32 v9, 192, v6
  v_and_b32 v48, 1, v0
  v_lshl_add_u32 v48, v48, 2, v18
  v_and_b32 v49, 13, v0
  v_xor_b32 v49, v21, v49
  v_lshlrev_b32 v49, 4, v49
  v_lshl_add_u32 v48, v48, 8, v49
  v_add_u32 v48, s40, v48
  v_xor_b32 v49, 64, v48
  v_xor_b32 v50, 128, v48
  v_xor_b32 v51, 192, v48
  v_bfe_u32 v53, v0, 2, 1
  v_lshl_add_u32 v53, v17, 2, v53
  v_xor_b32 v53, v21, v53
  v_lshlrev_b32 v53, 4, v53
  v_and_b32 v52, 7, v0
  v_lshl_add_u32 v52, v52, 8, v53
  v_add_u32 v52, s40, v52
  v_xor_b32 v53, 64, v52
  v_xor_b32 v54, 128, v52
  v_xor_b32 v55, 192, v52
  v_add_u32 v30, 0, v20
  v_and_b32 v30, 15, v30
  v_lshlrev_b32 v30, 4, v30
  v_lshl_add_u32 v30, v21, 8, v30
  v_add_u32 v30, s39, v30
  v_add_u32 v31, 4, v20
  v_and_b32 v31, 15, v31
  v_lshlrev_b32 v31, 4, v31
  v_lshl_add_u32 v31, v21, 8, v31
  v_add_u32 v31, s39, v31
  v_add_u32 v32, 8, v20
  v_and_b32 v32, 15, v32
  v_lshlrev_b32 v32, 4, v32
  v_lshl_add_u32 v32, v21, 8, v32
  v_add_u32 v32, s39, v32
  v_add_u32 v33, 12, v20
  v_and_b32 v33, 15, v33
  v_lshlrev_b32 v33, 4, v33
  v_lshl_add_u32 v33, v21, 8, v33
  v_add_u32 v33, s39, v33
  v_lshl_add_u32 v24, v19, 2, v16
  v_and_b32 v24, 15, v24
  v_lshlrev_b32 v24, 4, v24
  v_lshl_add_u32 v24, v21, 8, v24
  v_lshl_add_u32 v24, v17, 10, v24
  v_lshlrev_b32 v25, 3, v22
  s_add_u32 s3, s39, 0x10000
  v_add_u32 v28, s3, v25
  v_mov_b32 v29, v28
  v_add_u32 v25, 0x20400, v25
  v_lshl_add_u32 v26, v19, 9, v25
  v_lshlrev_b32 v27, 3, v21
  v_add_u32 v27, 0x20000, v27
  v_and_b32 v22, 7, v0
  v_lshl_add_u32 v22, v19, 3, v22
  v_lshl_add_u32 v22, v22, 5, v27
  v_lshl_add_u32 v27, v20, 5, v27
  v_lshlrev_b32 v23, 8, v20
  v_lshl_add_u32 v23, v21, 4, v23
  v_lshl_add_u32 v23, v19, 6, v23
  v_mov_b32 v36, s2
  s_and_b32 s3, s2, 0xe0
  v_add_u32 v37, s3, v1
  v_mov_b32 v56, 0
  v_mov_b32 v57, 0
  v_mov_b32 v58, 0
  v_mov_b32 v59, 0
  v_mov_b32 v35, 0
  s_getreg_b32 s43, hwreg(HW_REG_XCC_ID)
  s_and_b32 s43, s43, 1
  s_cmp_eq_u32 s43, 0
  s_cselect_b32 s43, -9, -4
  v_mov_b32 v76, 0
  v_mov_b32 v77, 0
  v_mov_b32 v78, 0
  v_mov_b32 v79, 0
  v_mov_b32 v80, 0
  v_mov_b32 v81, 0
  v_mov_b32 v82, 0
  v_mov_b32 v83, 0
  v_mov_b32 v84, 0
  v_mov_b32 v85, 0
  v_mov_b32 v86, 0
  v_mov_b32 v87, 0
  v_mov_b32 v88, 0
  v_mov_b32 v89, 0
  v_mov_b32 v90, 0
  v_mov_b32 v91, 0
  v_mov_b32 v152, 0
  v_mov_b32 v153, 0
  v_mov_b32 v155, 0
  v_mov_b32 v156, 0
  v_mov_b32 v157, 0
  v_mov_b32 v158, 0
  v_mov_b32 v160, 0
  v_mov_b32 v161, 0
  v_mov_b32 v163, 0
  v_mov_b32 v164, 0
  v_mov_b32 v165, 0
  v_mov_b32 v166, 0
  v_mov_b32 v168, 0
  v_mov_b32 v169, 0
  v_mov_b32 v171, 0
  v_mov_b32 v172, 0
  v_mov_b32 v173, 0
  v_mov_b32 v174, 0
  v_mov_b32 v176, 0
  v_mov_b32 v177, 0
  v_mov_b32 v179, 0
  v_mov_b32 v180, 0
  v_mov_b32 v181, 0
  v_mov_b32 v182, 0
  v_mov_b32 v184, 0
  v_mov_b32 v185, 0
  v_mov_b32 v16, 0
  s_mov_b32 s6, 0x1000
  s_waitcnt vmcnt(4)
  buffer_load_dwordx4 v5, s[16:19], s37 offen offset:3072 nt lds
  s_add_u32 s10, s10, 0x1000
  s_and_b32 s10, s10, 0x3000
  s_or_b32 m0, s10, s39
  s_add_u32 s7, s7, 0x8000
  s_lshr_b32 s3, s7, 5
  s_and_b32 s3, s3, 0x4000
  s_and_b32 s37, s7, 0x7ffff
  s_or_b32 s37, s37, s3
  s_xor_b32 s37, s37, s38
  s_waitcnt vmcnt(4)
  buffer_load_dwordx4 v2, s[16:19], s37 offen offset:0 nt lds
  s_waitcnt vmcnt(5)
  ds_read_b128 v[60:63], v48
  ds_read_b128 v[64:67], v49
  ds_read_b128 v[68:71], v50
  ds_read_b128 v[72:75], v51
  ds_read_b128 v[92:95], v52 offset:2048
  ds_read_b128 v[96:99], v53 offset:2048
  ds_read_b128 v[100:103], v54 offset:2048
  ds_read_b128 v[104:107], v55 offset:2048
  s_waitcnt vmcnt(4)
  buffer_load_dwordx4 v3, s[16:19], s37 offen offset:1024 nt lds
  s_waitcnt vmcnt(4)
  buffer_load_dwordx4 v4, s[16:19], s37 offen offset:2048 nt lds
  s_waitcnt lgkmcnt(0)
  v_dot2_f32_bf16 v17, v92, v92, 0
  v_dot2_f32_bf16 v18, v93, v93, 0
  v_dot2_f32_bf16 v17, v94, v94, v17
  v_dot2_f32_bf16 v18, v95, v95, v18
  v_dot2_f32_bf16 v17, v96, v96, v17
  v_dot2_f32_bf16 v18, v97, v97, v18
  v_dot2_f32_bf16 v17, v98, v98, v17
  v_dot2_f32_bf16 v18, v99, v99, v18
  v_dot2_f32_bf16 v17, v100, v100, v17
  v_dot2_f32_bf16 v18, v101, v101, v18
  v_dot2_f32_bf16 v17, v102, v102, v17
  v_dot2_f32_bf16 v18, v103, v103, v18
  v_dot2_f32_bf16 v17, v104, v104, v17
  v_dot2_f32_bf16 v18, v105, v105, v18
  v_dot2_f32_bf16 v17, v106, v106, v17
  v_dot2_f32_bf16 v18, v107, v107, v18
  s_waitcnt vmcnt(4)
  buffer_load_dwordx4 v5, s[16:19], s37 offen offset:3072 nt lds
  s_nop 2
  v_add_f32 v17, v17, v18
  s_nop 1
  v_mfma_f32_16x16x4_f32 v[44:47], v14, v17, 0
  v_mfma_f32_16x16x32_bf16 v[44:47], v[60:63], v[92:95], v[44:47]
  v_mfma_f32_16x16x32_bf16 v[44:47], v[64:67], v[96:99], v[44:47]
  v_mfma_f32_16x16x32_bf16 v[44:47], v[68:71], v[100:103], v[44:47]
  v_mfma_f32_16x16x32_bf16 v[44:47], v[72:75], v[104:107], v[44:47]
  s_add_u32 s10, s10, 0x1000
  s_and_b32 s10, s10, 0x3000
  s_or_b32 m0, s10, s39
  s_add_u32 s7, s7, 0x8000
  s_lshr_b32 s3, s7, 5
  s_and_b32 s3, s3, 0x4000
  s_and_b32 s37, s7, 0x7ffff
  s_or_b32 s37, s37, s3
  s_xor_b32 s37, s37, s38
  s_waitcnt vmcnt(4)
  buffer_load_dwordx4 v2, s[16:19], s37 offen offset:0 nt lds
  s_waitcnt vmcnt(5)
  s_nop 2
  ds_read_b128 v[92:95], v6 offset:0
  ds_read_b128 v[96:99], v7 offset:0
  ds_read_b128 v[100:103], v8 offset:0
  ds_read_b128 v[104:107], v9 offset:0
  v_fma_f32 v48, v44, v12, v13
  v_fma_f32 v49, v45, v12, v13
  v_exp_f32 v48, v48
  v_exp_f32 v49, v49
  s_nop 0
  v_add_f32 v48, 0x358637bd, v48
  v_add_f32 v49, 0x358637bd, v49
  ds_write_b64 v22, v[48:49]
  s_waitcnt vmcnt(4)
  buffer_load_dwordx4 v3, s[16:19], s37 offen offset:1024 nt lds
  s_waitcnt vmcnt(4)
  buffer_load_dwordx4 v4, s[16:19], s37 offen offset:2048 nt lds
  s_waitcnt vmcnt(4)
  buffer_load_dwordx4 v5, s[16:19], s37 offen offset:3072 nt lds
  v_mov_b32 v52, 0x358637bd
  v_mov_b32 v53, 0x358637bd
  v_mov_b32 v54, 0x358637bd
  v_mov_b32 v55, 0x358637bd
  s_mov_b32 s42, 14
L_k:
  v_sad_u8 v34, v56, 0, 0
  v_sad_u8 v34, v57, 0, v34
  v_sad_u8 v34, v58, 0, v34
  v_sad_u8 v34, v59, 0, v34
  v_add_u32 v35, 1, v35
  s_mov_b64 exec, 3
  v_readlane_b32 s8, v34, 0
  v_readlane_b32 s9, v34, 1
  buffer_store_byte v35, v36, s[12:15], 0 offen
  buffer_load_dwordx4 v[56:59], v37, s[12:15], 0 offen
  s_mov_b64 exec, -1
  s_add_u32 s8, s8, s9
  s_cmp_gt_i32 s8, s43
  s_cselect_b64 vcc, -1, 0
  s_add_u32 s43, s43, 32
  s_waitcnt lgkmcnt(0)
  v_dot2_f32_bf16 v17, v92, v92, 0
  v_dot2_f32_bf16 v18, v93, v93, 0
  v_dot2_f32_bf16 v17, v94, v94, v17
  v_dot2_f32_bf16 v18, v95, v95, v18
  v_dot2_f32_bf16 v17, v96, v96, v17
  v_dot2_f32_bf16 v18, v97, v97, v18
  v_dot2_f32_bf16 v17, v98, v98, v17
  v_dot2_f32_bf16 v18, v99, v99, v18
  v_dot2_f32_bf16 v17, v100, v100, v17
  v_dot2_f32_bf16 v18, v101, v101, v18
  v_dot2_f32_bf16 v17, v102, v102, v17
  v_dot2_f32_bf16 v18, v103, v103, v18
  v_dot2_f32_bf16 v17, v104, v104, v17
  v_dot2_f32_bf16 v18, v105, v105, v18
  v_dot2_f32_bf16 v17, v106, v106, v17
  v_dot2_f32_bf16 v18, v107, v107, v18
  s_add_u32 s10, s10, 0x1000
  s_and_b32 s10, s10, 0x3000
  s_or_b32 m0, s10, s39
  s_add_u32 s7, s7, 0x8000
  s_lshr_b32 s3, s7, 5
  s_and_b32 s3, s3, 0x4000
  s_and_b32 s37, s7, 0x7ffff
  s_or_b32 s37, s37, s3
  s_xor_b32 s37, s37, s38
  s_waitcnt vmcnt(7)
  s_cbranch_vccnz L_t1
  s_waitcnt vmcnt(6)
L_t1:
  buffer_load_dwordx4 v2, s[16:19], s37 offen offset:0 nt lds
  v_add_f32 v17, v17, v18
  s_nop 1
  v_mfma_f32_16x16x4_f32 v[44:47], v17, v14, 0
  v_mfma_f32_16x16x32_bf16 v[44:47], v[92:95], v[60:63], v[44:47]
  v_mfma_f32_16x16x32_bf16 v[44:47], v[96:99], v[64:67], v[44:47]
  v_mfma_f32_16x16x32_bf16 v[44:47], v[100:103], v[68:71], v[44:47]
  v_mfma_f32_16x16x32_bf16 v[44:47], v[104:107], v[72:75], v[44:47]
  s_waitcnt vmcnt(7)
  s_cbranch_vccnz L_t2
  s_waitcnt vmcnt(6)
L_t2:
  buffer_load_dwordx4 v3, s[16:19], s37 offen offset:1024 nt lds
  s_nop 4
  v_fma_f32 v48, v44, v12, v13
  v_fma_f32 v49, v45, v12, v13
  v_fma_f32 v50, v46, v12, v13
  v_fma_f32 v51, v47, v12, v13
  v_exp_f32 v48, v48
  v_exp_f32 v49, v49
  v_exp_f32 v50, v50
  v_exp_f32 v51, v51
  v_add_f32 v48, 0x358637bd, v48
  v_add_f32 v49, 0x358637bd, v49
  v_add_f32 v50, 0x358637bd, v50
  v_add_f32 v51, 0x358637bd, v51
  s_waitcnt vmcnt(7)
  s_cbranch_vccnz L_t3
  s_waitcnt vmcnt(6)
L_t3:
  buffer_load_dwordx4 v4, s[16:19], s37 offen offset:2048 nt lds
  v_add_f32 v17, v48, v49
  v_add_f32 v18, v50, v51
  v_cvt_pk_bf16_f32 v48, v48, v49
  v_cvt_pk_bf16_f32 v49, v50, v51
  v_add_f32 v16, v16, v17
  v_add_f32 v16, v16, v18
  ds_write_b64 v28, v[48:49] offset:0
  s_waitcnt vmcnt(7)
  s_cbranch_vccnz L_t4
  s_waitcnt vmcnt(6)
L_t4:
  buffer_load_dwordx4 v5, s[16:19], s37 offen offset:3072 nt lds
  s_waitcnt vmcnt(8)
  ds_read_b128 v[92:95], v6 offset:4096
  ds_read_b128 v[96:99], v7 offset:4096
  ds_read_b128 v[100:103], v8 offset:4096
  ds_read_b128 v[104:107], v9 offset:4096
  s_waitcnt lgkmcnt(0)
  v_dot2_f32_bf16 v17, v92, v92, 0
  v_dot2_f32_bf16 v18, v93, v93, 0
  v_dot2_f32_bf16 v17, v94, v94, v17
  v_dot2_f32_bf16 v18, v95, v95, v18
  v_dot2_f32_bf16 v17, v96, v96, v17
  v_dot2_f32_bf16 v18, v97, v97, v18
  v_dot2_f32_bf16 v17, v98, v98, v17
  v_dot2_f32_bf16 v18, v99, v99, v18
  v_dot2_f32_bf16 v17, v100, v100, v17
  v_dot2_f32_bf16 v18, v101, v101, v18
  v_dot2_f32_bf16 v17, v102, v102, v17
  v_dot2_f32_bf16 v18, v103, v103, v18
  v_dot2_f32_bf16 v17, v104, v104, v17
  v_dot2_f32_bf16 v18, v105, v105, v18
  v_dot2_f32_bf16 v17, v106, v106, v17
  v_dot2_f32_bf16 v18, v107, v107, v18
  s_add_u32 s10, s10, 0x1000
  s_and_b32 s10, s10, 0x3000
  s_or_b32 m0, s10, s39
  s_add_u32 s7, s7, 0x8000
  s_lshr_b32 s3, s7, 5
  s_and_b32 s3, s3, 0x4000
  s_and_b32 s37, s7, 0x7ffff
  s_or_b32 s37, s37, s3
  s_xor_b32 s37, s37, s38
  s_waitcnt vmcnt(7)
  s_cbranch_vccnz L_t5
  s_waitcnt vmcnt(6)
L_t5:
  buffer_load_dwordx4 v2, s[16:19], s37 offen offset:0 nt lds
  v_add_f32 v17, v17, v18
  s_nop 1
  v_mfma_f32_16x16x4_f32 v[44:47], v17, v14, 0
  v_mfma_f32_16x16x32_bf16 v[44:47], v[92:95], v[60:63], v[44:47]
  v_mfma_f32_16x16x32_bf16 v[44:47], v[96:99], v[64:67], v[44:47]
  v_mfma_f32_16x16x32_bf16 v[44:47], v[100:103], v[68:71], v[44:47]
  v_mfma_f32_16x16x32_bf16 v[44:47], v[104:107], v[72:75], v[44:47]
  s_waitcnt vmcnt(7)
  s_cbranch_vccnz L_t6
  s_waitcnt vmcnt(4)
L_t6:
  buffer_load_dwordx4 v3, s[16:19], s37 offen offset:1024 nt lds
  s_nop 4
  v_fma_f32 v48, v44, v12, v13
  v_fma_f32 v49, v45, v12, v13
  v_fma_f32 v50, v46, v12, v13
  v_fma_f32 v51, v47, v12, v13
  v_exp_f32 v48, v48
  v_exp_f32 v49, v49
  v_exp_f32 v50, v50
  v_exp_f32 v51, v51
  v_add_f32 v48, 0x358637bd, v48
  v_add_f32 v49, 0x358637bd, v49
  v_add_f32 v50, 0x358637bd, v50
  v_add_f32 v51, 0x358637bd, v51
  s_waitcnt vmcnt(5)
  s_cbranch_vccnz L_t7
  s_waitcnt vmcnt(4)
L_t7:
  buffer_load_dwordx4 v4, s[16:19], s37 offen offset:2048 nt lds
  v_add_f32 v17, v48, v49
  v_add_f32 v18, v50, v51
  v_cvt_pk_bf16_f32 v48, v48, v49
  v_cvt_pk_bf16_f32 v49, v50, v51
  v_add_f32 v16, v16, v17
  v_add_f32 v16, v16, v18
  ds_write_b64 v28, v[48:49] offset:512
  s_waitcnt vmcnt(5)
  s_cbranch_vccnz L_t8
  s_waitcnt vmcnt(4)
L_t8:
  buffer_load_dwordx4 v5, s[16:19], s37 offen offset:3072 nt lds
  v_xor_b32 v6, 0x2000, v6
  v_xor_b32 v7, 0x2000, v7
  v_xor_b32 v8, 0x2000, v8
  v_xor_b32 v9, 0x2000, v9
  s_waitcnt vmcnt(8)
  ds_read_b128 v[92:95], v6 offset:0
  ds_read_b128 v[96:99], v7 offset:0
  ds_read_b128 v[100:103], v8 offset:0
  ds_read_b128 v[104:107], v9 offset:0
  v_add_u32 v28, 1024, v28
  s_sub_u32 s42, s42, 1
  s_cmp_lg_u32 s42, 0
  s_cbranch_scc1 L_k
L_trans:
  v_sad_u8 v34, v56, 0, 0
  v_sad_u8 v34, v57, 0, v34
  v_sad_u8 v34, v58, 0, v34
  v_sad_u8 v34, v59, 0, v34
  v_add_u32 v35, 1, v35
  s_mov_b64 exec, 3
  v_readlane_b32 s8, v34, 0
  v_readlane_b32 s9, v34, 1
  buffer_store_byte v35, v36, s[12:15], 0 offen
  buffer_load_dwordx4 v[56:59], v37, s[12:15], 0 offen
  s_mov_b64 exec, -1
  s_add_u32 s8, s8, s9
  s_cmp_gt_i32 s8, s43
  s_cselect_b64 vcc, -1, 0
  s_add_u32 s43, s43, 32
  s_waitcnt lgkmcnt(0)
  v_dot2_f32_bf16 v17, v92, v92, 0
  v_dot2_f32_bf16 v18, v93, v93, 0
  v_dot2_f32_bf16 v17, v94, v94, v17
  v_dot2_f32_bf16 v18, v95, v95, v18
  v_dot2_f32_bf16 v17, v96, v96, v17
  v_dot2_f32_bf16 v18, v97, v97, v18
  v_dot2_f32_bf16 v17, v98, v98, v17
  v_dot2_f32_bf16 v18, v99, v99, v18
  v_dot2_f32_bf16 v17, v100, v100, v17
  v_dot2_f32_bf16 v18, v101, v101, v18
  v_dot2_f32_bf16 v17, v102, v102, v17
  v_dot2_f32_bf16 v18, v103, v103, v18
  v_dot2_f32_bf16 v17, v104, v104, v17
  v_dot2_f32_bf16 v18, v105, v105, v18
  v_dot2_f32_bf16 v17, v106, v106, v17
  v_dot2_f32_bf16 v18, v107, v107, v18
  s_add_u32 s10, s10, 0x1000
  s_and_b32 s10, s10, 0x3000
  s_or_b32 m0, s10, s39
  s_add_u32 s7, s7, 0x8000
  s_lshr_b32 s3, s7, 5
  s_and_b32 s3, s3, 0x4000
  s_and_b32 s37, s7, 0x7ffff
  s_or_b32 s37, s37, s3
  s_xor_b32 s37, s37, s38
  s_waitcnt vmcnt(7)
  s_cbranch_vccnz L_t9
  s_waitcnt vmcnt(6)
L_t9:
  buffer_load_dwordx4 v2, s[16:19], s37 offen offset:0 nt lds
  v_add_f32 v17, v17, v18
  s_nop 1
  v_mfma_f32_16x16x4_f32 v[44:47], v17, v14, 0
  v_mfma_f32_16x16x32_bf16 v[44:47], v[92:95], v[60:63], v[44:47]
  v_mfma_f32_16x16x32_bf16 v[44:47], v[96:99], v[64:67], v[44:47]
  v_mfma_f32_16x16x32_bf16 v[44:47], v[100:103], v[68:71], v[44:47]
  v_mfma_f32_16x16x32_bf16 v[44:47], v[104:107], v[72:75], v[44:47]
  s_waitcnt vmcnt(7)
  s_cbranch_vccnz L_t10
  s_waitcnt vmcnt(6)
L_t10:
  buffer_load_dwordx4 v3, s[16:19], s37 offen offset:1024 nt lds
  s_nop 4
  v_fma_f32 v48, v44, v12, v13
  v_fma_f32 v49, v45, v12, v13
  v_fma_f32 v50, v46, v12, v13
  v_fma_f32 v51, v47, v12, v13
  v_exp_f32 v48, v48
  v_exp_f32 v49, v49
  v_exp_f32 v50, v50
  v_exp_f32 v51, v51
  v_add_f32 v48, 0x358637bd, v48
  v_add_f32 v49, 0x358637bd, v49
  v_add_f32 v50, 0x358637bd, v50
  v_add_f32 v51, 0x358637bd, v51
  s_waitcnt vmcnt(7)
  s_cbranch_vccnz L_t11
  s_waitcnt vmcnt(6)
L_t11:
  buffer_load_dwordx4 v4, s[16:19], s37 offen offset:2048 nt lds
  v_add_f32 v17, v48, v49
  v_add_f32 v18, v50, v51
  v_cvt_pk_bf16_f32 v48, v48, v49
  v_cvt_pk_bf16_f32 v49, v50, v51
  v_add_f32 v16, v16, v17
  v_add_f32 v16, v16, v18
  ds_write_b64 v28, v[48:49] offset:0
  s_waitcnt vmcnt(7)
  s_cbranch_vccnz L_t12
  s_waitcnt vmcnt(6)
L_t12:
  buffer_load_dwordx4 v5, s[16:19], s37 offen offset:3072 nt lds
  s_waitcnt vmcnt(8)
  ds_read_b128 v[92:95], v6 offset:4096
  ds_read_b128 v[96:99], v7 offset:4096
  ds_read_b128 v[100:103], v8 offset:4096
  ds_read_b128 v[104:107], v9 offset:4096
  s_mov_b32 s7, 0xffff8000
  s_waitcnt lgkmcnt(0)
  v_dot2_f32_bf16 v17, v92, v92, 0
  v_dot2_f32_bf16 v18, v93, v93, 0
  v_dot2_f32_bf16 v17, v94, v94, v17
  v_dot2_f32_bf16 v18, v95, v95, v18
  v_dot2_f32_bf16 v17, v96, v96, v17
  v_dot2_f32_bf16 v18, v97, v97, v18
  v_dot2_f32_bf16 v17, v98, v98, v17
  v_dot2_f32_bf16 v18, v99, v99, v18
  v_dot2_f32_bf16 v17, v100, v100, v17
  v_dot2_f32_bf16 v18, v101, v101, v18
  v_dot2_f32_bf16 v17, v102, v102, v17
  v_dot2_f32_bf16 v18, v103, v103, v18
  v_dot2_f32_bf16 v17, v104, v104, v17
  v_dot2_f32_bf16 v18, v105, v105, v18
  v_dot2_f32_bf16 v17, v106, v106, v17
  v_dot2_f32_bf16 v18, v107, v107, v18
  s_add_u32 s7, s7, 0x8000
  s_lshr_b32 s3, s7, 5
  s_and_b32 s3, s3, 0x4000
  s_and_b32 s37, s7, 0x7ffff
  s_or_b32 s37, s37, s3
  s_xor_b32 s37, s37, s38
  s_waitcnt vmcnt(7)
  s_cbranch_vccnz L_t13
  s_waitcnt vmcnt(6)
L_t13:
  buffer_load_dwordx4 v[108:111], v1, s[20:23], s37 offen offset:0 nt
  v_add_f32 v17, v17, v18
  s_nop 1
  v_mfma_f32_16x16x4_f32 v[44:47], v17, v14, 0
  v_mfma_f32_16x16x32_bf16 v[44:47], v[92:95], v[60:63], v[44:47]
  v_mfma_f32_16x16x32_bf16 v[44:47], v[96:99], v[64:67], v[44:47]
  v_mfma_f32_16x16x32_bf16 v[44:47], v[100:103], v[68:71], v[44:47]
  v_mfma_f32_16x16x32_bf16 v[44:47], v[104:107], v[72:75], v[44:47]
  s_waitcnt vmcnt(7)
  s_cbranch_vccnz L_t14
  s_waitcnt vmcnt(4)
L_t14:
  buffer_load_dwordx4 v[112:115], v1, s[20:23], s37 offen offset:1024 nt
  s_nop 4
  v_fma_f32 v48, v44, v12, v13
  v_fma_f32 v49, v45, v12, v13
  v_fma_f32 v50, v46, v12, v13
  v_fma_f32 v51, v47, v12, v13
  v_exp_f32 v48, v48
  v_exp_f32 v49, v49
  v_exp_f32 v50, v50
  v_exp_f32 v51, v51
  v_add_f32 v48, 0x358637bd, v48
  v_add_f32 v49, 0x358637bd, v49
  v_add_f32 v50, 0x358637bd, v50
  v_add_f32 v51, 0x358637bd, v51
  s_waitcnt vmcnt(5)
  s_cbranch_vccnz L_t15
  s_waitcnt vmcnt(4)
L_t15:
  buffer_load_dwordx4 v[116:119], v1, s[20:23], s37 offen offset:2048 nt
  v_add_f32 v17, v48, v49
  v_add_f32 v18, v50, v51
  v_cvt_pk_bf16_f32 v48, v48, v49
  v_cvt_pk_bf16_f32 v49, v50, v51
  v_add_f32 v16, v16, v17
  v_add_f32 v16, v16, v18
  ds_write_b64 v28, v[48:49] offset:512
  s_waitcnt vmcnt(5)
  s_cbranch_vccnz L_t16
  s_waitcnt vmcnt(4)
L_t16:
  buffer_load_dwordx4 v[120:123], v1, s[20:23], s37 offen offset:3072 nt
  v_xor_b32 v6, 0x2000, v6
  v_xor_b32 v7, 0x2000, v7
  v_xor_b32 v8, 0x2000, v8
  v_xor_b32 v9, 0x2000, v9
  s_waitcnt vmcnt(8)
  ds_read_b128 v[92:95], v6 offset:0
  ds_read_b128 v[96:99], v7 offset:0
  ds_read_b128 v[100:103], v8 offset:0
  ds_read_b128 v[104:107], v9 offset:0
  v_sad_u8 v34, v56, 0, 0
  v_sad_u8 v34, v57, 0, v34
  v_sad_u8 v34, v58, 0, v34
  v_sad_u8 v34, v59, 0, v34
  v_add_u32 v35, 1, v35
  s_mov_b64 exec, 3
  v_readlane_b32 s8, v34, 0
  v_readlane_b32 s9, v34, 1
  buffer_store_byte v35, v36, s[12:15], 0 offen
  buffer_load_dwordx4 v[56:59], v37, s[12:15], 0 offen
  s_mov_b64 exec, -1
  s_add_u32 s8, s8, s9
  s_cmp_gt_i32 s8, s43
  s_cselect_b64 vcc, -1, 0
  s_add_u32 s43, s43, 32
  s_waitcnt lgkmcnt(0)
  v_dot2_f32_bf16 v17, v92, v92, 0
  v_dot2_f32_bf16 v18, v93, v93, 0
  v_dot2_f32_bf16 v17, v94, v94, v17
  v_dot2_f32_bf16 v18, v95, v95, v18
  v_dot2_f32_bf16 v17, v96, v96, v17
  v_dot2_f32_bf16 v18, v97, v97, v18
  v_dot2_f32_bf16 v17, v98, v98, v17
  v_dot2_f32_bf16 v18, v99, v99, v18
  v_dot2_f32_bf16 v17, v100, v100, v17
  v_dot2_f32_bf16 v18, v101, v101, v18
  v_dot2_f32_bf16 v17, v102, v102, v17
  v_dot2_f32_bf16 v18, v103, v103, v18
  v_dot2_f32_bf16 v17, v104, v104, v17
  v_dot2_f32_bf16 v18, v105, v105, v18
  v_dot2_f32_bf16 v17, v106, v106, v17
  v_dot2_f32_bf16 v18, v107, v107, v18
  s_add_u32 s7, s7, 0x8000
  s_lshr_b32 s3, s7, 5
  s_and_b32 s3, s3, 0x4000
  s_and_b32 s37, s7, 0x7ffff
  s_or_b32 s37, s37, s3
  s_xor_b32 s37, s37, s38
  s_waitcnt vmcnt(7)
  s_cbranch_vccnz L_t17
  s_waitcnt vmcnt(6)
L_t17:
  buffer_load_dwordx4 v[124:127], v1, s[20:23], s37 offen offset:0 nt
  v_add_f32 v17, v17, v18
  s_nop 1
  v_mfma_f32_16x16x4_f32 v[44:47], v17, v14, 0
  v_mfma_f32_16x16x32_bf16 v[44:47], v[92:95], v[60:63], v[44:47]
  v_mfma_f32_16x16x32_bf16 v[44:47], v[96:99], v[64:67], v[44:47]
  v_mfma_f32_16x16x32_bf16 v[44:47], v[100:103], v[68:71], v[44:47]
  v_mfma_f32_16x16x32_bf16 v[44:47], v[104:107], v[72:75], v[44:47]
  s_waitcnt vmcnt(7)
  s_cbranch_vccnz L_t18
  s_waitcnt vmcnt(6)
L_t18:
  buffer_load_dwordx4 v[128:131], v1, s[20:23], s37 offen offset:1024 nt
  s_nop 4
  v_fma_f32 v48, v44, v12, v13
  v_fma_f32 v49, v45, v12, v13
  v_fma_f32 v50, v46, v12, v13
  v_fma_f32 v51, v47, v12, v13
  v_exp_f32 v48, v48
  v_exp_f32 v49, v49
  v_exp_f32 v50, v50
  v_exp_f32 v51, v51
  v_add_f32 v48, 0x358637bd, v48
  v_add_f32 v49, 0x358637bd, v49
  v_add_f32 v50, 0x358637bd, v50
  v_add_f32 v51, 0x358637bd, v51
  s_waitcnt vmcnt(7)
  s_cbranch_vccnz L_t19
  s_waitcnt vmcnt(6)
L_t19:
  buffer_load_dwordx4 v[132:135], v1, s[20:23], s37 offen offset:2048 nt
  v_add_f32 v17, v48, v49
  v_add_f32 v18, v50, v51
  v_cvt_pk_bf16_f32 v48, v48, v49
  v_cvt_pk_bf16_f32 v49, v50, v51
  v_add_f32 v16, v16, v17
  v_add_f32 v16, v16, v18
  ds_write_b64 v28, v[48:49] offset:1024
  ds_read_b64 v[40:41], v29 offset:0
  ds_read_b64 v[42:43], v29 offset:512
  s_waitcnt vmcnt(7)
  s_cbranch_vccnz L_t20
  s_waitcnt vmcnt(6)
L_t20:
  buffer_load_dwordx4 v[136:139], v1, s[20:23], s37 offen offset:3072 nt
  s_waitcnt vmcnt(8)
  ds_read_b128 v[92:95], v6 offset:4096
  ds_read_b128 v[96:99], v7 offset:4096
  ds_read_b128 v[100:103], v8 offset:4096
  ds_read_b128 v[104:107], v9 offset:4096
  s_waitcnt lgkmcnt(0)
  v_dot2_f32_bf16 v17, v92, v92, 0
  v_dot2_f32_bf16 v18, v93, v93, 0
  v_dot2_f32_bf16 v17, v94, v94, v17
  v_dot2_f32_bf16 v18, v95, v95, v18
  v_dot2_f32_bf16 v17, v96, v96, v17
  v_dot2_f32_bf16 v18, v97, v97, v18
  v_dot2_f32_bf16 v17, v98, v98, v17
  v_dot2_f32_bf16 v18, v99, v99, v18
  v_dot2_f32_bf16 v17, v100, v100, v17
  v_dot2_f32_bf16 v18, v101, v101, v18
  v_dot2_f32_bf16 v17, v102, v102, v17
  v_dot2_f32_bf16 v18, v103, v103, v18
  v_dot2_f32_bf16 v17, v104, v104, v17
  v_dot2_f32_bf16 v18, v105, v105, v18
  v_dot2_f32_bf16 v17, v106, v106, v17
  v_dot2_f32_bf16 v18, v107, v107, v18
  v_perm_b32 v154, v40, v40, v10
  v_perm_b32 v159, v40, v40, v10
  v_perm_b32 v162, v40, v40, v11
  v_perm_b32 v167, v40, v40, v11
  v_perm_b32 v170, v41, v41, v10
  v_perm_b32 v175, v41, v41, v10
  v_perm_b32 v178, v41, v41, v11
  v_perm_b32 v183, v41, v41, v11
  ds_read_b64 v[40:41], v29 offset:1024
  s_add_u32 s7, s7, 0x8000
  s_lshr_b32 s3, s7, 5
  s_and_b32 s3, s3, 0x4000
  s_and_b32 s37, s7, 0x7ffff
  s_or_b32 s37, s37, s3
  s_xor_b32 s37, s37, s38
  v_add_f32 v17, v17, v18
  s_nop 1
  v_mfma_f32_16x16x4_f32 v[44:47], v17, v14, 0
  v_mfma_f32_16x16x32_bf16 v[44:47], v[92:95], v[60:63], v[44:47]
  v_mfma_f32_16x16x32_bf16 v[44:47], v[96:99], v[64:67], v[44:47]
  v_mfma_f32_16x16x32_bf16 v[44:47], v[100:103], v[68:71], v[44:47]
  v_mfma_f32_16x16x32_bf16 v[44:47], v[104:107], v[72:75], v[44:47]
  s_waitcnt vmcnt(7)
  v_mfma_f32_16x16x32_bf16 v[76:79], v[154:157], v[108:111], v[76:79]
  v_mfma_f32_16x16x32_bf16 v[80:83], v[158:161], v[108:111], v[80:83]
  v_mfma_f32_16x16x32_bf16 v[84:87], v[152:155], v[108:111], v[84:87]
  v_mfma_f32_16x16x32_bf16 v[88:91], v[156:159], v[108:111], v[88:91]
  v_perm_b32 v154, v42, v42, v10
  v_perm_b32 v159, v42, v42, v10
  s_waitcnt vmcnt(7)
  s_cbranch_vccnz L_t21
  s_waitcnt vmcnt(6)
L_t21:
  buffer_load_dwordx4 v[108:111], v1, s[20:23], s37 offen offset:0 nt
  v_fma_f32 v48, v44, v12, v13
  v_fma_f32 v49, v45, v12, v13
  v_fma_f32 v50, v46, v12, v13
  v_fma_f32 v51, v47, v12, v13
  v_exp_f32 v48, v48
  v_exp_f32 v49, v49
  v_exp_f32 v50, v50
  v_exp_f32 v51, v51
  v_add_f32 v48, 0x358637bd, v48
  v_add_f32 v49, 0x358637bd, v49
  v_add_f32 v50, 0x358637bd, v50
  v_add_f32 v51, 0x358637bd, v51
  s_waitcnt vmcnt(7)
  v_mfma_f32_16x16x32_bf16 v[76:79], v[162:165], v[112:115], v[76:79]
  v_mfma_f32_16x16x32_bf16 v[80:83], v[166:169], v[112:115], v[80:83]
  v_mfma_f32_16x16x32_bf16 v[84:87], v[160:163], v[112:115], v[84:87]
  v_mfma_f32_16x16x32_bf16 v[88:91], v[164:167], v[112:115], v[88:91]
  v_perm_b32 v162, v42, v42, v11
  v_perm_b32 v167, v42, v42, v11
  s_waitcnt vmcnt(7)
  s_cbranch_vccnz L_t22
  s_waitcnt vmcnt(4)
L_t22:
  buffer_load_dwordx4 v[112:115], v1, s[20:23], s37 offen offset:1024 nt
  v_add_f32 v17, v48, v49
  v_add_f32 v18, v50, v51
  v_cvt_pk_bf16_f32 v48, v48, v49
  v_cvt_pk_bf16_f32 v49, v50, v51
  v_add_f32 v16, v16, v17
  v_add_f32 v16, v16, v18
  ds_write_b64 v28, v[48:49] offset:1536
  s_waitcnt vmcnt(7)
  v_mfma_f32_16x16x32_bf16 v[76:79], v[170:173], v[116:119], v[76:79]
  v_mfma_f32_16x16x32_bf16 v[80:83], v[174:177], v[116:119], v[80:83]
  v_mfma_f32_16x16x32_bf16 v[84:87], v[168:171], v[116:119], v[84:87]
  v_mfma_f32_16x16x32_bf16 v[88:91], v[172:175], v[116:119], v[88:91]
  v_perm_b32 v170, v43, v43, v10
  v_perm_b32 v175, v43, v43, v10
  s_waitcnt vmcnt(5)
  s_cbranch_vccnz L_t23
  s_waitcnt vmcnt(4)
L_t23:
  buffer_load_dwordx4 v[116:119], v1, s[20:23], s37 offen offset:2048 nt
  s_waitcnt vmcnt(7)
  v_mfma_f32_16x16x32_bf16 v[76:79], v[178:181], v[120:123], v[76:79]
  v_mfma_f32_16x16x32_bf16 v[80:83], v[182:185], v[120:123], v[80:83]
  v_mfma_f32_16x16x32_bf16 v[84:87], v[176:179], v[120:123], v[84:87]
  v_mfma_f32_16x16x32_bf16 v[88:91], v[180:183], v[120:123], v[88:91]
  v_perm_b32 v178, v43, v43, v11
  v_perm_b32 v183, v43, v43, v11
  s_waitcnt vmcnt(5)
  s_cbranch_vccnz L_t24
  s_waitcnt vmcnt(4)
L_t24:
  buffer_load_dwordx4 v[120:123], v1, s[20:23], s37 offen offset:3072 nt
  v_add_u32 v29, 1536, v29
  s_mov_b32 s42, 14
L_v:
  v_sad_u8 v34, v56, 0, 0
  v_sad_u8 v34, v57, 0, v34
  v_sad_u8 v34, v58, 0, v34
  v_sad_u8 v34, v59, 0, v34
  v_add_u32 v35, 1, v35
  s_mov_b64 exec, 3
  v_readlane_b32 s8, v34, 0
  v_readlane_b32 s9, v34, 1
  buffer_store_byte v35, v36, s[12:15], 0 offen
  buffer_load_dwordx4 v[56:59], v37, s[12:15], 0 offen
  s_mov_b64 exec, -1
  s_add_u32 s8, s8, s9
  s_cmp_gt_i32 s8, s43
  s_cselect_b64 vcc, -1, 0
  s_add_u32 s43, s43, 32
  s_waitcnt lgkmcnt(0)
  ds_read_b64 v[42:43], v29 offset:0
  s_add_u32 s7, s7, 0x8000
  s_lshr_b32 s3, s7, 5
  s_and_b32 s3, s3, 0x4000
  s_and_b32 s37, s7, 0x7ffff
  s_or_b32 s37, s37, s3
  s_xor_b32 s37, s37, s38
  s_waitcnt vmcnt(7)
  v_mfma_f32_16x16x32_bf16 v[76:79], v[154:157], v[124:127], v[76:79]
  v_mfma_f32_16x16x32_bf16 v[80:83], v[158:161], v[124:127], v[80:83]
  v_mfma_f32_16x16x32_bf16 v[84:87], v[152:155], v[124:127], v[84:87]
  v_mfma_f32_16x16x32_bf16 v[88:91], v[156:159], v[124:127], v[88:91]
  v_perm_b32 v154, v40, v40, v10
  v_perm_b32 v159, v40, v40, v10
  s_waitcnt vmcnt(7)
  s_cbranch_vccnz L_t25
  s_waitcnt vmcnt(6)
L_t25:
  buffer_load_dwordx4 v[124:127], v1, s[20:23], s37 offen offset:0 nt
  s_waitcnt vmcnt(7)
  v_mfma_f32_16x16x32_bf16 v[76:79], v[162:165], v[128:131], v[76:79]
  v_mfma_f32_16x16x32_bf16 v[80:83], v[166:169], v[128:131], v[80:83]
  v_mfma_f32_16x16x32_bf16 v[84:87], v[160:163], v[128:131], v[84:87]
  v_mfma_f32_16x16x32_bf16 v[88:91], v[164:167], v[128:131], v[88:91]
  v_perm_b32 v162, v40, v40, v11
  v_perm_b32 v167, v40, v40, v11
  s_waitcnt vmcnt(7)
  s_cbranch_vccnz L_t26
  s_waitcnt vmcnt(6)
L_t26:
  buffer_load_dwordx4 v[128:131], v1, s[20:23], s37 offen offset:1024 nt
  s_waitcnt vmcnt(7)
  v_mfma_f32_16x16x32_bf16 v[76:79], v[170:173], v[132:135], v[76:79]
  v_mfma_f32_16x16x32_bf16 v[80:83], v[174:177], v[132:135], v[80:83]
  v_mfma_f32_16x16x32_bf16 v[84:87], v[168:171], v[132:135], v[84:87]
  v_mfma_f32_16x16x32_bf16 v[88:91], v[172:175], v[132:135], v[88:91]
  v_perm_b32 v170, v41, v41, v10
  v_perm_b32 v175, v41, v41, v10
  s_waitcnt vmcnt(7)
  s_cbranch_vccnz L_t27
  s_waitcnt vmcnt(6)
L_t27:
  buffer_load_dwordx4 v[132:135], v1, s[20:23], s37 offen offset:2048 nt
  s_waitcnt vmcnt(7)
  v_mfma_f32_16x16x32_bf16 v[76:79], v[178:181], v[136:139], v[76:79]
  v_mfma_f32_16x16x32_bf16 v[80:83], v[182:185], v[136:139], v[80:83]
  v_mfma_f32_16x16x32_bf16 v[84:87], v[176:179], v[136:139], v[84:87]
  v_mfma_f32_16x16x32_bf16 v[88:91], v[180:183], v[136:139], v[88:91]
  v_perm_b32 v178, v41, v41, v11
  v_perm_b32 v183, v41, v41, v11
  s_waitcnt vmcnt(7)
  s_cbranch_vccnz L_t28
  s_waitcnt vmcnt(6)
L_t28:
  buffer_load_dwordx4 v[136:139], v1, s[20:23], s37 offen offset:3072 nt
  s_waitcnt lgkmcnt(0)
  ds_read_b64 v[40:41], v29 offset:512
  s_add_u32 s7, s7, 0x8000
  s_lshr_b32 s3, s7, 5
  s_and_b32 s3, s3, 0x4000
  s_and_b32 s37, s7, 0x7ffff
  s_or_b32 s37, s37, s3
  s_xor_b32 s37, s37, s38
  s_waitcnt vmcnt(7)
  v_mfma_f32_16x16x32_bf16 v[76:79], v[154:157], v[108:111], v[76:79]
  v_mfma_f32_16x16x32_bf16 v[80:83], v[158:161], v[108:111], v[80:83]
  v_mfma_f32_16x16x32_bf16 v[84:87], v[152:155], v[108:111], v[84:87]
  v_mfma_f32_16x16x32_bf16 v[88:91], v[156:159], v[108:111], v[88:91]
  v_perm_b32 v154, v42, v42, v10
  v_perm_b32 v159, v42, v42, v10
  s_waitcnt vmcnt(7)
  s_cbranch_vccnz L_t29
  s_waitcnt vmcnt(6)
L_t29:
  buffer_load_dwordx4 v[108:111], v1, s[20:23], s37 offen offset:0 nt
  s_waitcnt vmcnt(7)
  v_mfma_f32_16x16x32_bf16 v[76:79], v[162:165], v[112:115], v[76:79]
  v_mfma_f32_16x16x32_bf16 v[80:83], v[166:169], v[112:115], v[80:83]
  v_mfma_f32_16x16x32_bf16 v[84:87], v[160:163], v[112:115], v[84:87]
  v_mfma_f32_16x16x32_bf16 v[88:91], v[164:167], v[112:115], v[88:91]
  v_perm_b32 v162, v42, v42, v11
  v_perm_b32 v167, v42, v42, v11
  s_waitcnt vmcnt(7)
  s_cbranch_vccnz L_t30
  s_waitcnt vmcnt(4)
L_t30:
  buffer_load_dwordx4 v[112:115], v1, s[20:23], s37 offen offset:1024 nt
  s_waitcnt vmcnt(7)
  v_mfma_f32_16x16x32_bf16 v[76:79], v[170:173], v[116:119], v[76:79]
  v_mfma_f32_16x16x32_bf16 v[80:83], v[174:177], v[116:119], v[80:83]
  v_mfma_f32_16x16x32_bf16 v[84:87], v[168:171], v[116:119], v[84:87]
  v_mfma_f32_16x16x32_bf16 v[88:91], v[172:175], v[116:119], v[88:91]
  v_perm_b32 v170, v43, v43, v10
  v_perm_b32 v175, v43, v43, v10
  s_waitcnt vmcnt(5)
  s_cbranch_vccnz L_t31
  s_waitcnt vmcnt(4)
L_t31:
  buffer_load_dwordx4 v[116:119], v1, s[20:23], s37 offen offset:2048 nt
  s_waitcnt vmcnt(7)
  v_mfma_f32_16x16x32_bf16 v[76:79], v[178:181], v[120:123], v[76:79]
  v_mfma_f32_16x16x32_bf16 v[80:83], v[182:185], v[120:123], v[80:83]
  v_mfma_f32_16x16x32_bf16 v[84:87], v[176:179], v[120:123], v[84:87]
  v_mfma_f32_16x16x32_bf16 v[88:91], v[180:183], v[120:123], v[88:91]
  v_perm_b32 v178, v43, v43, v11
  v_perm_b32 v183, v43, v43, v11
  s_waitcnt vmcnt(5)
  s_cbranch_vccnz L_t32
  s_waitcnt vmcnt(4)
L_t32:
  buffer_load_dwordx4 v[120:123], v1, s[20:23], s37 offen offset:3072 nt
  v_add_u32 v29, 1024, v29
  s_sub_u32 s42, s42, 1
  s_cmp_lg_u32 s42, 0
  s_cbranch_scc1 L_v
  s_add_u32 s7, s7, 0x8000
  s_lshr_b32 s3, s7, 5
  s_and_b32 s3, s3, 0x4000
  s_and_b32 s37, s7, 0x7ffff
  s_or_b32 s37, s37, s3
  s_xor_b32 s37, s37, s38
  buffer_load_dwordx4 v[60:63], v1, s[20:23], s37 offen offset:0 nt
  buffer_load_dwordx4 v[64:67], v1, s[20:23], s37 offen offset:1024 nt
  buffer_load_dwordx4 v[68:71], v1, s[20:23], s37 offen offset:2048 nt
  buffer_load_dwordx4 v[72:75], v1, s[20:23], s37 offen offset:3072 nt
  v_mfma_f32_16x16x4_f32 v[44:47], v16, v15, 0
  s_waitcnt lgkmcnt(0)
  ds_read_b64 v[42:43], v29 offset:0
  s_waitcnt vmcnt(11)
  v_mfma_f32_16x16x32_bf16 v[76:79], v[154:157], v[124:127], v[76:79]
  v_mfma_f32_16x16x32_bf16 v[80:83], v[158:161], v[124:127], v[80:83]
  v_mfma_f32_16x16x32_bf16 v[84:87], v[152:155], v[124:127], v[84:87]
  v_mfma_f32_16x16x32_bf16 v[88:91], v[156:159], v[124:127], v[88:91]
  v_perm_b32 v154, v40, v40, v10
  v_perm_b32 v159, v40, v40, v10
  s_nop 0
  ds_write_b64 v26, v[44:45]
  s_waitcnt vmcnt(10)
  v_mfma_f32_16x16x32_bf16 v[76:79], v[162:165], v[128:131], v[76:79]
  v_mfma_f32_16x16x32_bf16 v[80:83], v[166:169], v[128:131], v[80:83]
  v_mfma_f32_16x16x32_bf16 v[84:87], v[160:163], v[128:131], v[84:87]
  v_mfma_f32_16x16x32_bf16 v[88:91], v[164:167], v[128:131], v[88:91]
  v_perm_b32 v162, v40, v40, v11
  v_perm_b32 v167, v40, v40, v11
  s_waitcnt lgkmcnt(0)
  s_barrier
  ds_read_b64 v[92:93], v25 offset:0
  ds_read_b64 v[94:95], v25 offset:512
  ds_read_b64 v[96:97], v25 offset:1024
  ds_read_b64 v[98:99], v25 offset:1536
  ds_read_b64 v[140:141], v27 offset:0
  ds_read_b64 v[142:143], v27 offset:512
  s_waitcnt vmcnt(9)
  v_mfma_f32_16x16x32_bf16 v[76:79], v[170:173], v[132:135], v[76:79]
  v_mfma_f32_16x16x32_bf16 v[80:83], v[174:177], v[132:135], v[80:83]
  v_mfma_f32_16x16x32_bf16 v[84:87], v[168:171], v[132:135], v[84:87]
  v_mfma_f32_16x16x32_bf16 v[88:91], v[172:175], v[132:135], v[88:91]
  v_perm_b32 v170, v41, v41, v10
  v_perm_b32 v175, v41, v41, v10
  s_waitcnt lgkmcnt(0)
  v_pk_add_f32 v[92:93], v[92:93], v[94:95]
  v_pk_add_f32 v[96:97], v[96:97], v[98:99]
  v_pk_add_f32 v[92:93], v[92:93], v[96:97]
  v_mul_f32 v94, v140, v92
  v_mul_f32 v95, v142, v92
  v_fmac_f32 v94, v141, v93
  v_fmac_f32 v95, v143, v93
  s_nop 1
  v_mfma_f32_16x16x4_f32 v[100:103], v15, v94, v[52:55]
  v_mfma_f32_16x16x4_f32 v[104:107], v15, v95, v[52:55]
  s_waitcnt vmcnt(8)
  v_mfma_f32_16x16x32_bf16 v[76:79], v[178:181], v[136:139], v[76:79]
  v_mfma_f32_16x16x32_bf16 v[80:83], v[182:185], v[136:139], v[80:83]
  v_mfma_f32_16x16x32_bf16 v[84:87], v[176:179], v[136:139], v[84:87]
  v_mfma_f32_16x16x32_bf16 v[88:91], v[180:183], v[136:139], v[88:91]
  v_perm_b32 v178, v41, v41, v11
  v_perm_b32 v183, v41, v41, v11
  v_mov_b32 v127, 0
  v_mov_b32 v131, 0
  s_nop 0
  s_waitcnt vmcnt(7)
  v_mfma_f32_16x16x32_bf16 v[76:79], v[154:157], v[108:111], v[76:79]
  v_rcp_f32 v100, v100
  v_rcp_f32 v104, v104
  v_mfma_f32_16x16x32_bf16 v[80:83], v[158:161], v[108:111], v[80:83]
  v_mov_b32 v147, 0
  v_mov_b32 v151, 0
  v_mfma_f32_16x16x32_bf16 v[84:87], v[152:155], v[108:111], v[84:87]
  v_mul_f32 v140, v140, v100
  v_mul_f32 v141, v141, v100
  v_mfma_f32_16x16x32_bf16 v[88:91], v[156:159], v[108:111], v[88:91]
  v_mul_f32 v142, v142, v104
  v_mul_f32 v143, v143, v104
  v_perm_b32 v154, v42, v42, v10
  v_perm_b32 v159, v42, v42, v10
  s_waitcnt vmcnt(6)
  v_mfma_f32_16x16x32_bf16 v[76:79], v[162:165], v[112:115], v[76:79]
  v_cvt_pk_bf16_f32 v144, v140, v141
  v_cvt_pk_bf16_f32 v148, v142, v143
  v_mfma_f32_16x16x32_bf16 v[80:83], v[166:169], v[112:115], v[80:83]
  v_lshlrev_b32 v92, 16, v144
  v_and_b32 v93, 0xffff0000, v144
  v_mfma_f32_16x16x32_bf16 v[84:87], v[160:163], v[112:115], v[84:87]
  v_lshlrev_b32 v94, 16, v148
  v_and_b32 v95, 0xffff0000, v148
  v_mfma_f32_16x16x32_bf16 v[88:91], v[164:167], v[112:115], v[88:91]
  v_sub_f32 v92, v140, v92
  v_sub_f32 v93, v141, v93
  v_perm_b32 v162, v42, v42, v11
  v_perm_b32 v167, v42, v42, v11
  s_waitcnt vmcnt(5)
  v_mfma_f32_16x16x32_bf16 v[76:79], v[170:173], v[116:119], v[76:79]
  v_sub_f32 v94, v142, v94
  v_sub_f32 v95, v143, v95
  v_mfma_f32_16x16x32_bf16 v[80:83], v[174:177], v[116:119], v[80:83]
  v_cvt_pk_bf16_f32 v145, v92, v93
  v_cvt_pk_bf16_f32 v149, v94, v95
  v_mfma_f32_16x16x32_bf16 v[84:87], v[168:171], v[116:119], v[84:87]
  v_mov_b32 v146, v144
  v_mov_b32 v150, v148
  v_mfma_f32_16x16x32_bf16 v[88:91], v[172:175], v[116:119], v[88:91]
  v_perm_b32 v170, v43, v43, v10
  v_perm_b32 v175, v43, v43, v10
  s_waitcnt vmcnt(4)
  v_mfma_f32_16x16x32_bf16 v[76:79], v[178:181], v[120:123], v[76:79]
  v_mfma_f32_16x16x32_bf16 v[80:83], v[182:185], v[120:123], v[80:83]
  v_mfma_f32_16x16x32_bf16 v[84:87], v[176:179], v[120:123], v[84:87]
  v_mfma_f32_16x16x32_bf16 v[88:91], v[180:183], v[120:123], v[88:91]
  v_perm_b32 v178, v43, v43, v11
  v_perm_b32 v183, v43, v43, v11
  s_nop 0
  s_waitcnt vmcnt(3)
  v_mfma_f32_16x16x32_bf16 v[76:79], v[154:157], v[60:63], v[76:79]
  v_mfma_f32_16x16x32_bf16 v[80:83], v[158:161], v[60:63], v[80:83]
  v_mfma_f32_16x16x32_bf16 v[84:87], v[152:155], v[60:63], v[84:87]
  v_mfma_f32_16x16x32_bf16 v[88:91], v[156:159], v[60:63], v[88:91]
  s_waitcnt vmcnt(2)
  v_mfma_f32_16x16x32_bf16 v[76:79], v[162:165], v[64:67], v[76:79]
  v_mfma_f32_16x16x32_bf16 v[80:83], v[166:169], v[64:67], v[80:83]
  v_mfma_f32_16x16x32_bf16 v[84:87], v[160:163], v[64:67], v[84:87]
  v_mfma_f32_16x16x32_bf16 v[88:91], v[164:167], v[64:67], v[88:91]
  s_waitcnt vmcnt(1)
  v_mfma_f32_16x16x32_bf16 v[76:79], v[170:173], v[68:71], v[76:79]
  v_mfma_f32_16x16x32_bf16 v[80:83], v[174:177], v[68:71], v[80:83]
  v_mfma_f32_16x16x32_bf16 v[84:87], v[168:171], v[68:71], v[84:87]
  v_mfma_f32_16x16x32_bf16 v[88:91], v[172:175], v[68:71], v[88:91]
  s_waitcnt vmcnt(0)
  v_mfma_f32_16x16x32_bf16 v[76:79], v[178:181], v[72:75], v[76:79]
  v_mfma_f32_16x16x32_bf16 v[80:83], v[182:185], v[72:75], v[80:83]
  v_mfma_f32_16x16x32_bf16 v[84:87], v[176:179], v[72:75], v[84:87]
  v_mfma_f32_16x16x32_bf16 v[88:91], v[180:183], v[72:75], v[88:91]
  s_nop 4
  ds_write_b128 v30, v[76:79] offset:0
  ds_write_b128 v31, v[80:83] offset:1024
  ds_write_b128 v32, v[84:87] offset:2048
  ds_write_b128 v33, v[88:91] offset:3072
  s_waitcnt lgkmcnt(0)
  s_barrier
  ds_read_b128 v[92:95], v24 offset:0
  ds_read_b128 v[96:99], v24 offset:16384
  ds_read_b128 v[100:103], v24 offset:32768
  ds_read_b128 v[104:107], v24 offset:49152
  s_waitcnt lgkmcnt(2)
  v_pk_add_f32 v[92:93], v[92:93], v[96:97]
  v_pk_add_f32 v[94:95], v[94:95], v[98:99]
  s_waitcnt lgkmcnt(1)
  v_pk_add_f32 v[92:93], v[92:93], v[100:101]
  v_pk_add_f32 v[94:95], v[94:95], v[102:103]
  s_waitcnt lgkmcnt(0)
  v_pk_add_f32 v[92:93], v[92:93], v[104:105]
  v_pk_add_f32 v[94:95], v[94:95], v[106:107]
  v_cvt_pk_bf16_f32 v124, v92, v93
  v_cvt_pk_bf16_f32 v128, v94, v95
  v_lshlrev_b32 v96, 16, v124
  v_and_b32 v97, 0xffff0000, v124
  v_lshlrev_b32 v98, 16, v128
  v_and_b32 v99, 0xffff0000, v128
  v_pk_add_f32 v[92:93], v[92:93], v[96:97] neg_lo:[0,1] neg_hi:[0,1]
  v_pk_add_f32 v[94:95], v[94:95], v[98:99] neg_lo:[0,1] neg_hi:[0,1]
  v_cvt_pk_bf16_f32 v126, v92, v93
  v_cvt_pk_bf16_f32 v130, v94, v95
  v_mov_b32 v125, v124
  v_mov_b32 v129, v128
  s_nop 1
  v_mfma_f32_16x16x32_bf16 v[108:111], v[124:127], v[144:147], 0
  v_mfma_f32_16x16x32_bf16 v[112:115], v[128:131], v[144:147], 0
  v_mfma_f32_16x16x32_bf16 v[116:119], v[124:127], v[148:151], 0
  v_mfma_f32_16x16x32_bf16 v[120:123], v[128:131], v[148:151], 0
  s_nop 5
  v_cvt_pk_bf16_f32 v108, v108, v112
  v_cvt_pk_bf16_f32 v109, v109, v113
  v_cvt_pk_bf16_f32 v110, v110, v114
  v_cvt_pk_bf16_f32 v111, v111, v115
  buffer_store_dwordx4 v[108:111], v23, s[32:35], 0 offen
  v_cvt_pk_bf16_f32 v116, v116, v120
  v_cvt_pk_bf16_f32 v117, v117, v121
  v_cvt_pk_bf16_f32 v118, v118, v122
  v_cvt_pk_bf16_f32 v119, v119, v123
  buffer_store_dwordx4 v[116:119], v23, s[32:35], s6 offen
L_end:
  s_endpgm
.section .rodata,"a"
.p2align 6
.amdhsa_kernel standalone__linear_kernel_rfa__sampling_kernel
  .amdhsa_next_free_vgpr 186
  .amdhsa_next_free_sgpr 48
  .amdhsa_accum_offset 188
  .amdhsa_group_segment_fixed_size 0
  .amdhsa_kernarg_size 56
  .amdhsa_user_sgpr_count 2
  .amdhsa_user_sgpr_kernarg_segment_ptr 1
  .amdhsa_system_sgpr_workgroup_id_x 1
  .amdhsa_float_denorm_mode_32 3
.end_amdhsa_kernel
```
